```python
import torch

def _softmax(x, axis=-1):
    return torch.softmax(x, dim=axis)
def _gelu(x):
    return torch.nn.functional.gelu(x, approximate="tanh")
def _silu(x):
    return torch.nn.functional.silu(x)
def _sigmoid(x):
    return torch.sigmoid(x)
def _layernorm(x, axis=-1, eps=1e-5):
    m = x.mean(dim=axis, keepdim=True)
    v = x.var(dim=axis, keepdim=True, unbiased=False)
    return (x - m) / torch.sqrt(v + eps)
def _scatter_add(tgt, idx, src, axis=0):
    return tgt.clone().index_add_(axis, idx, src)
def _segment_sum(src, seg, n):
    out = torch.zeros((n,) + src.shape[1:], dtype=src.dtype)
    return out.index_add_(0, seg, src)
def _pad(x, pw):
    flat = tuple(v for pair in reversed(pw) for v in pair)
    return torch.nn.functional.pad(x, flat)

kernel_name = 'interleave_layers__spectral_fnet__moe_arch_mod__prompt'

def setup_inputs():

    _w = (lambda a: (lambda t: t.to(torch.bfloat16) if t.is_floating_point() else t)(torch.as_tensor(a)))
    def _A_setup():
        B, S, D = 1, 2048, 512
        ns = torch.arange(S)[:, None] * torch.arange(S)[None, :]
        nd = torch.arange(D)[:, None] * torch.arange(D)[None, :]
        Ws_re = torch.cos(-2.0 * torch.pi * ns / S).to(float)
        Ws_im = torch.sin(-2.0 * torch.pi * ns / S).to(float)
        Wd_re = torch.cos(-2.0 * torch.pi * nd / D).to(float)
        Wd_im = torch.sin(-2.0 * torch.pi * nd / D).to(float)
        return {
            "x": _w((lambda *s: torch.randn(*s, dtype=torch.bfloat16) * 0.05)(B, S, D)),
            "dft_seq_re": _w(Ws_re),
            "dft_seq_im": _w(Ws_im),
            "dft_hid_re": _w(Wd_re),
            "dft_hid_im": _w(Wd_im),
        }
    _A_in = _A_setup()

    def _B_setup():
        B, S, D, F, C = 1, 2048, 512, 1792, 1
        return {
            "x": _w((lambda *s: torch.randn(*s, dtype=torch.bfloat16) * 0.05)(B, S, D)),
            "w_r": _w((lambda *s: torch.randn(*s, dtype=torch.bfloat16) * 1.6)(D)),
            "w_gate": _w((lambda *s: torch.randn(*s, dtype=torch.bfloat16) * 0.4)(D, F)),
            "w_up": _w((lambda *s: torch.randn(*s, dtype=torch.bfloat16) * 0.4)(D, F)),
            "w_down": _w((lambda *s: torch.randn(*s, dtype=torch.bfloat16) * 0.4)(F, D)),
        }
    _B_in = _B_setup()

    return {
        "A_x": _A_in["x"],
        "A_dft_seq_re": _A_in["dft_seq_re"],
        "A_dft_seq_im": _A_in["dft_seq_im"],
        "A_dft_hid_re": _A_in["dft_hid_re"],
        "A_dft_hid_im": _A_in["dft_hid_im"],
        "B_x": _B_in["x"],
        "B_w_r": _B_in["w_r"],
        "B_w_gate": _B_in["w_gate"],
        "B_w_up": _B_in["w_up"],
        "B_w_down": _B_in["w_down"],
    }

def reference(A_x, A_dft_seq_re, A_dft_seq_im, A_dft_hid_re, A_dft_hid_im, B_x, B_w_r, B_w_gate, B_w_up, B_w_down):
    def _A_ref(x, dft_seq_re, dft_seq_im, dft_hid_re, dft_hid_im):
        a = torch.einsum("bsd,ed->bse", x, dft_hid_re)
        b = torch.einsum("bsd,ed->bse", x, dft_hid_im)
        y = torch.einsum("ts,bse->bte", dft_seq_re, a) - torch.einsum("ts,bse->bte", dft_seq_im, b)
        return y

    def _B_ref(x, w_r, w_gate, w_up, w_down):
        B, S, D = x.shape
        C = 1
        r = x @ w_r
        idx = torch.argsort(-r, axis=-1)[:, :C]
        idx_e = (lambda x, n, axis: torch.repeat_interleave(x, n, dim=axis))(idx.reshape(B, C, 1), D, axis=2)
        x_sel = (lambda x, i, axis: torch.take_along_dim(x, i, dim=axis))(x, idx_e, axis=1)
        g = _silu(x_sel @ w_gate)
        u = x_sel @ w_up
        y = (g * u) @ w_down
        r_sel = _sigmoid((lambda x, i, axis: torch.take_along_dim(x, i, dim=axis))(r, idx, axis=1))
        y = y * r_sel.reshape(B, C, 1)
        b_off = (torch.arange(B) * S).reshape(B, 1)
        flat_idx = (idx + b_off).reshape(B * C)
        zero = (x * 0.0).reshape(B * S, D)
        upd = _scatter_add(zero, flat_idx, y.reshape(B * C, D), axis=0)
        return x + upd.reshape(B, S, D)

    x = A_x
    x = x + _A_ref(_layernorm(x, axis=-1), A_dft_seq_re, A_dft_seq_im, A_dft_hid_re, A_dft_hid_im)
    x = x + _B_ref(_layernorm(x, axis=-1), B_w_r, B_w_gate, B_w_up, B_w_down)
    x = x + _A_ref(_layernorm(x, axis=-1), A_dft_seq_re, A_dft_seq_im, A_dft_hid_re, A_dft_hid_im)
    x = x + _B_ref(_layernorm(x, axis=-1), B_w_r, B_w_gate, B_w_up, B_w_down)
    return x
```

```asm
; @launch grid=(512,1,1) block=(512,1,1) lds=33408
.amdgcn_target "amdgcn-amd-amdhsa--gfx950"
.text
.globl interleave_layers__spectral_fnet__moe_arch_mod__prompt_kernel
.p2align 12
.p2align 8
.type interleave_layers__spectral_fnet__moe_arch_mod__prompt_kernel,@function
interleave_layers__spectral_fnet__moe_arch_mod__prompt_kernel:
    s_load_dwordx2 s[12:13], s[0:1], 0
    s_load_dwordx2 s[8:9], s[0:1], 96
    s_load_dwordx8 s[16:23], s[0:1], 48
    s_load_dwordx2 s[28:29], s[0:1], 80
    v_and_b32 v90, 15, v0
    v_bfe_u32 v91, v0, 4, 2
    v_lshrrev_b32 v2, 6, v0
    v_lshlrev_b32 v75, 7, v2
    v_lshl_add_u32 v75, v90, 3, v75
    v_lshl_add_u32 v72, v91, 19, v75
    s_and_b32 s26, s2, 7
    s_lshr_b32 s27, s2, 3
    s_and_b32 s4, s27, 15
    s_lshl4_add_u32 s4, s4, s26
    s_sub_u32 s5, 256, s4
    s_bitcmp1_b32 s27, 4
    s_cselect_b32 s4, s5, s4
    s_cselect_b32 s5, 0x80008000, 0
    s_cmp_eq_u32 s26, 0
    s_cselect_b32 s4, s2, s4
    s_cselect_b32 s5, 0, s5
    s_lshl_b32 s48, s4, 10
    s_add_u32 s49, s48, 0x40000
    s_mov_b32 s14, 0x200000
    s_mov_b32 s15, 0x20000
    v_readfirstlane_b32 s3, v2
    s_getpc_b64 s[70:71]
L_pc:
    v_lshlrev_b32 v3, 6, v0
    v_cmp_gt_u32 vcc, L_end-L_pc, v3
    s_xor_b32 s64, s2, 0
    s_and_b32 s64, s64, 280
    s_cselect_b64 vcc, 0, vcc
    s_cbranch_vccz L_npf
    s_mov_b64 exec, vcc
    global_load_dword v93, v3, s[70:71]
    s_mov_b64 exec, -1
L_npf:
    s_cmp_ge_u32 s2, 256
    s_cbranch_scc1 L_nox
    s_waitcnt lgkmcnt(0)
    buffer_load_dwordx2 v[58:59], v72, s[12:15], s48 offen
    buffer_load_dwordx2 v[60:61], v72, s[12:15], s49 offen
L_nox:
    s_cmp_ge_u32 s2, 512
    s_cbranch_scc1 L_end
    v_and_b32 v92, 63, v0
    s_mov_b32 s10, 8388608
    s_mov_b32 s11, 0x20000
    s_mov_b32 s30, 0x200000
    s_mov_b32 s31, 0x20000
    v_mov_b32 v106, -1
    v_mov_b32 v107, -1
    v_mov_b32 v108, -1
    v_mov_b32 v109, -1
    v_lshlrev_b32 v88, 3, v0
    v_and_b32 v88, 0xf8, v88
    s_mov_b32 s50, 200000
    s_mov_b32 s60, 0x7ff
    s_lshl_b32 s46, s26, 8
    s_add_u32 s46, s46, 8192
    s_getreg_b32 s51, hwreg(HW_REG_XCC_ID, 0, 4)
    s_cmp_ge_u32 s2, 256
    s_cbranch_scc1 L_ffn
    s_setprio 2
    s_cmp_gt_u32 s3, 1
    s_cbranch_scc1 L_np
    s_setprio 3
L_np:
    s_mul_i32 s40, s26, 270336
    s_add_u32 s40, s40, 262144
    s_mul_i32 s39, s27, 8448
    s_add_u32 s39, s39, s40
    v_lshlrev_b32 v102, 4, v0
    v_lshrrev_b32 v103, 4, v0
    buffer_load_dwordx4 v[66:69], v102, s[8:11], s39 offen sc1
    s_mov_b32 s43, 2490368
    s_mul_i32 s64, s26, 131840
    s_add_u32 s66, s27, 24
    s_and_b32 s66, s66, 24
    s_lshl_b32 s66, s66, 12
    s_add_u32 s64, s64, s66
    s_cmp_gt_u32 s3, 3
    s_cselect_b32 s64, s10, s64
    s_and_b32 s66, s27, 7
    s_cmp_lt_u32 s27, 8
    s_cselect_b32 s67, 7, 8
    s_cselect_b32 s68, 112, 0
    s_lshl_b32 s66, s66, s67
    s_add_u32 s64, s64, s66
    v_lshlrev_b32 v104, 4, v90
    v_lshl_add_u32 v84, v103, 11, v104
    v_and_b32 v105, 8, v90
    v_mad_u32_u24 v84, v105, s68, v84
    v_add_u32 v84, s64, v84
    buffer_store_dwordx4 v[106:109], v84, s[8:11], s43 offen sc1
    v_and_b32 v64, 0x3f0, v102
    global_load_dwordx2 v[62:63], v75, s[16:17]
    global_load_dwordx4 v[10:13], v64, s[16:17]
    s_cmp_lg_u32 s3, 0
    s_cbranch_scc1 L_nw0
    buffer_load_dword v70, off, s[8:11], 0 sc1
    buffer_load_dword v65, v88, s[8:11], s46 offen sc1
    s_and_b32 s78, s27, 24
    s_add_u32 s78, s78, s26
    s_and_b32 s77, s27, 7
    s_lshl3_add_u32 s79, s78, s77
    s_lshl_b32 s79, s79, 10
    s_cmp_lt_u32 s78, 4
    s_cselect_b32 s79, s10, s79
    buffer_store_dwordx4 v[106:109], v102, s[8:11], s79 offen sc1
L_nw0:
    s_lshr_b32 s64, s27, 2
    s_and_b32 s64, s64, 6
    s_lshl_b32 s65, s3, 2
    s_and_b32 s65, s65, 8
    s_cmp_lt_u32 s27, 8
    s_cselect_b32 s64, s65, s64
    s_cselect_b32 s68, 0, -1
    s_mov_b32 s69, 0x44440054
    s_cmp_eq_u32 s26, 0
    s_cselect_b32 s68, 1, s68
    s_cselect_b32 s69, s69, 0x55550054
    s_cselect_b32 s66, 0, 1
    s_lshl_b32 s64, s64, s66
    s_lshl_b32 s65, s3, 4
    s_and_b32 s65, s65, 16
    s_mul_i32 s66, s65, s68
    s_cmp_ge_u32 s3, 4
    s_cselect_b32 s66, s66, 0
    s_cselect_b32 s64, s64, 0
    s_cmp_eq_u32 s3, 3
    s_cselect_b32 s64, 16, s64
    s_lshl_b32 s67, s3, 2
    s_lshr_b32 s67, s69, s67
    s_and_b32 s67, s67, 15
    v_lshlrev_b32 v110, s67, v90
    v_add_u32 v110, s64, v110
    v_lshl_add_u32 v111, v91, 2, s66
    v_cvt_f32_u32 v110, v110
    v_cvt_f32_i32 v111, v111
    s_mov_b32 s52, 0x3b000000
    v_mul_f32 v110, s52, v110
    v_mul_f32 v114, v111, v110
    v_add_f32 v115, v114, v110
    v_add_f32 v116, v115, v110
    v_add_f32 v117, v116, v110
    v_cos_f32 v118, v114
    s_mov_b32 s54, 0x3727c5ac
    v_sin_f32 v122, v114
    s_mov_b32 s55, 0x3727c5ac
    v_cos_f32 v119, v115
    s_mov_b32 s56, 0x3d800000
    v_sin_f32 v123, v115
    s_mov_b32 s57, 0x3d800000
    v_cos_f32 v120, v116
    s_mov_b32 s61, 0x80000000
    v_sin_f32 v124, v116
    s_mov_b32 s62, 0x11111111
    v_cos_f32 v121, v117
    s_mov_b32 s63, 0x11111111
    v_sin_f32 v125, v117
    s_mov_b32 s44, 3017728
    s_lshl_b32 s64, s3, 11
    s_add_u32 s64, s64, 9216
    v_lshlrev_b32 v112, 4, v92
    v_add_u32 v113, s64, v112
    s_and_b32 s64, s3, 6
    s_cmp_eq_u32 s64, 2
    s_cbranch_scc1 L_cw
    s_cmp_eq_u32 s3, 1
    s_cbranch_scc1 L_cri
    v_cvt_pk_f16_f32 v118, v118, v119
    v_cvt_pk_f16_f32 v119, v120, v121
    v_cvt_pk_f16_f32 v120, v122, v123
    v_cvt_pk_f16_f32 v121, v124, v125
    s_nop 0
    s_branch L_cw
L_cri:
    v_cvt_pk_f16_f32 v114, v118, v122
    v_cvt_pk_f16_f32 v122, -v122, v118
    v_mov_b32 v118, v114
    v_xor_b32 v122, s5, v122
    v_cvt_pk_f16_f32 v114, v119, v123
    v_cvt_pk_f16_f32 v123, -v123, v119
    v_mov_b32 v119, v114
    v_xor_b32 v123, s5, v123
    v_cvt_pk_f16_f32 v114, v120, v124
    v_cvt_pk_f16_f32 v124, -v124, v120
    v_mov_b32 v120, v114
    v_xor_b32 v124, s5, v124
    v_cvt_pk_f16_f32 v114, v121, v125
    v_cvt_pk_f16_f32 v125, -v125, v121
    v_mov_b32 v121, v114
    v_xor_b32 v125, s5, v125
L_cw:
    ds_write_b128 v113, v[118:121]
    ds_write_b128 v113, v[122:125] offset:1024
    v_lshrrev_b32 v114, 2, v90
    v_and_b32 v115, 2, v90
    v_and_b32 v116, 14, v90
    v_cmp_eq_u32 vcc, 2, v116
    v_lshlrev_b32 v74, 8, v91
    s_nop 0
    v_cndmask_b32 v114, v114, 4, vcc
    v_cndmask_b32 v115, v115, 0, vcc
    v_mul_u32_u24 v116, v114, v91
    v_lshl_add_u32 v116, v116, 1, v115
    v_add_u32 v117, v116, v114
    v_cvt_f32_u32 v116, v116
    v_cvt_f32_u32 v117, v117
    v_mul_f32 v116, 0x3e000000, v116
    v_mul_f32 v117, 0x3e000000, v117
    v_cos_f32 v116, v116
    v_cos_f32 v117, v117
    v_and_b32 v115, 1, v90
    v_cmp_eq_u32 vcc, 0, v115
    v_cvt_pk_f16_f32 v116, v116, v117
    v_mov_b32 v115, 0x80008000
    v_cndmask_b32 v14, 0, v116, vcc
    v_cndmask_b32 v15, v116, 0, vcc
    v_cndmask_b32 v115, v115, 0, vcc
    s_lshl_b32 s65, s65, 7
    v_add_u32 v116, s65, v112
    s_lshl_b32 s66, s3, 10
    s_and_b32 s66, s66, 4096
    v_add_u32 v117, s66, v112
    s_waitcnt lgkmcnt(0)
    s_barrier
    ds_read_b128 v[28:31], v112 offset:9216
    ds_read_b128 v[40:43], v112 offset:11264
    ds_read_b128 v[44:47], v112 offset:12288
    ds_read_b128 v[32:35], v116 offset:13312
    ds_read_b128 v[36:39], v116 offset:14336
    ds_read2st64_b64 v[48:51], v117 offset0:34 offset1:38
    v_add_u32 v117, 8, v117
    ds_read2st64_b64 v[52:55], v117 offset0:34 offset1:38
    v_and_b32 v114, 4, v90
    s_lshl_b32 s64, s3, 2
    v_lshl_add_u32 v73, v105, 2, v74
    v_lshl_add_u32 v73, v114, 4, v73
    v_add_u32 v73, s64, v73
    v_and_b32 v114, 7, v90
    v_lshl_add_u32 v74, v114, 5, v74
    v_lshl_add_u32 v75, v91, 11, v75
    v_add_u32 v75, 1024, v75
    s_lshr_b32 s64, s3, 1
    s_lshl_b32 s64, s64, 11
    s_add_u32 s66, s64, 1024
    v_lshl_add_u32 v76, v92, 3, s66
    s_lshr_b32 s66, s65, 5
    s_add_u32 s64, s64, s66
    v_lshl_add_u32 v77, v91, 9, s64
    v_lshl_add_u32 v77, v90, 2, v77
    s_lshl_b32 s67, s3, 31
    s_mov_b32 s69, 0x80008000
    s_mov_b32 s32, 0
    s_waitcnt lgkmcnt(6)
    v_xor_b32 v20, s67, v28
    v_xor_b32 v21, s67, v29
    v_xor_b32 v24, s67, v30
    v_xor_b32 v25, s67, v31
    v_xor_b32 v22, v20, v115
    v_xor_b32 v23, v21, v115
    v_xor_b32 v26, v24, v115
    v_xor_b32 v27, v25, v115
    v_xor_b32 v28, s69, v24
    v_xor_b32 v29, s69, v25
    v_xor_b32 v30, s69, v26
    v_xor_b32 v31, s69, v27
    s_waitcnt lgkmcnt(0)
    v_lshrrev_b32 v111, 4, v0
    v_lshlrev_b32 v112, 4, v90
    v_lshrrev_b32 v81, 2, v90
    v_mul_u32_u24 v81, 288, v81
    s_lshl_b32 s65, s3, 5
    s_add_u32 s64, s65, 19456
    v_mul_u32_u24 v82, 272, v90
    v_lshl_add_u32 v82, v91, 3, v82
    v_add_u32 v82, s64, v82
    v_mul_u32_u24 v83, 272, v111
    v_add_u32 v83, v83, v112
    v_add_u32 v83, 19456, v83
    s_add_u32 s65, s65, 9216
    v_mul_u32_u24 v113, 1152, v91
    v_and_b32 v114, 0x18, v88
    v_add3_u32 v81, v81, v113, v114
    v_add_u32 v81, s65, v81
    s_cmp_lt_u32 s27, 8
    s_cbranch_scc1 L_aself
    v_mul_u32_u24 v78, 8448, v111
    v_mul_u32_u24 v80, 288, v111
    s_lshl_b32 s64, s27, 8
    v_add3_u32 v78, v78, v112, s64
    v_add_u32 v80, v80, v112
    v_mov_b32 v79, 0
    s_nop 0
    s_branch L_adone
L_aself:
    s_lshl_b32 s64, s3, 2
    s_and_b32 s64, s64, 24
    v_lshrrev_b32 v113, 3, v92
    v_add_u32 v113, s64, v113
    v_and_b32 v114, 0x70, v112
    v_mul_u32_u24 v79, 8448, v113
    v_mul_u32_u24 v80, 288, v113
    s_lshl_b32 s64, s27, 7
    s_add_u32 s65, s64, 4
    s_sub_u32 s64, 2032, s64
    v_add3_u32 v78, v79, v114, s65
    v_sub_u32 v79, v79, v114
    v_add_u32 v79, s64, v79
    s_and_b32 s64, s3, 1
    s_lshl_b32 s64, s64, 7
    v_add3_u32 v80, v80, v114, s64
L_adone:
    v_add_u32 v80, 9216, v80
    s_waitcnt vmcnt(7)
    s_cmp_eq_u32 s3, 0
    s_cbranch_scc1 L_x0
    s_waitcnt vmcnt(4)
L_x0:
    v_lshlrev_b32 v2, 16, v58
    v_and_b32 v4, 0xffff0000, v58
    v_lshlrev_b32 v6, 16, v59
    v_and_b32 v8, 0xffff0000, v59
    v_lshlrev_b32 v3, 16, v60
    v_and_b32 v5, 0xffff0000, v60
    v_lshlrev_b32 v7, 16, v61
    v_and_b32 v9, 0xffff0000, v61
L_top:
    v_pk_add_f32 v[102:103], v[2:3], v[4:5]
    v_pk_add_f32 v[108:109], v[6:7], v[8:9]
    v_pk_mul_f32 v[104:105], v[2:3], v[2:3]
    v_pk_mul_f32 v[106:107], v[2:3], v[10:11] op_sel:[0,0] op_sel_hi:[1,0]
    v_pk_add_f32 v[102:103], v[102:103], v[108:109]
    v_pk_fma_f32 v[104:105], v[4:5], v[4:5], v[104:105]
    v_pk_fma_f32 v[106:107], v[4:5], v[10:11], v[106:107] op_sel:[0,1,0] op_sel_hi:[1,1,1]
    v_add_f32_dpp v102, v102, v102 row_ror:8 row_mask:0xf bank_mask:0x3
    v_pk_fma_f32 v[104:105], v[6:7], v[6:7], v[104:105]
    v_pk_fma_f32 v[106:107], v[6:7], v[12:13], v[106:107] op_sel:[0,0,0] op_sel_hi:[1,0,1]
    v_add_f32_dpp v102, v103, v103 row_ror:8 row_mask:0xf bank_mask:0xc
    v_pk_fma_f32 v[104:105], v[8:9], v[8:9], v[104:105]
    v_pk_fma_f32 v[106:107], v[8:9], v[12:13], v[106:107] op_sel:[0,1,0] op_sel_hi:[1,1,1]
    v_add_f32_dpp v102, v102, v102 row_half_mirror row_mask:0xf bank_mask:0x5
    v_add_f32_dpp v104, v104, v104 row_ror:8 row_mask:0xf bank_mask:0x3
    v_add_f32_dpp v106, v106, v106 row_ror:8 row_mask:0xf bank_mask:0x3
    s_nop 0
    v_add_f32_dpp v104, v105, v105 row_ror:8 row_mask:0xf bank_mask:0xc
    v_add_f32_dpp v106, v107, v107 row_ror:8 row_mask:0xf bank_mask:0xc
    s_nop 0
    v_add_f32_dpp v102, v104, v104 row_half_mirror row_mask:0xf bank_mask:0xa
    v_add_f32_dpp v106, v106, v106 row_half_mirror row_mask:0xf bank_mask:0xf
    s_nop 0
    v_add_f32_dpp v102, v102, v102 quad_perm:[1,0,3,2] row_mask:0xf bank_mask:0xf
    v_add_f32_dpp v106, v106, v106 quad_perm:[1,0,3,2] row_mask:0xf bank_mask:0xf
    s_nop 0
    v_add_f32_dpp v102, v102, v102 quad_perm:[2,3,0,1] row_mask:0xf bank_mask:0xf
    v_add_f32_dpp v106, v106, v106 quad_perm:[2,3,0,1] row_mask:0xf bank_mask:0xf
    s_mov_b64 exec, s[62:63]
    ds_write2_b32 v73, v102, v106 offset0:0 offset1:32
    s_mov_b64 exec, -1
    s_waitcnt lgkmcnt(0)
    s_barrier
    ds_read_b128 v[102:105], v74
    ds_read_b128 v[106:109], v74 offset:16
    s_waitcnt lgkmcnt(0)
    v_pk_add_f32 v[102:103], v[102:103], v[104:105]
    v_pk_add_f32 v[106:107], v[106:107], v[108:109]
    v_pk_add_f32 v[102:103], v[102:103], v[106:107]
    v_add_f32 v102, v102, v103
    v_mul_f32 v109, s52, v102
    s_nop 1
    v_mov_b32_dpp v98, v109 row_newbcast:0 row_mask:0xf bank_mask:0xf
    v_mov_b32_dpp v99, v109 row_newbcast:1 row_mask:0xf bank_mask:0xf
    v_mov_b32_dpp v104, v109 row_newbcast:2 row_mask:0xf bank_mask:0xf
    v_mov_b32_dpp v105, v109 row_newbcast:3 row_mask:0xf bank_mask:0xf
    v_pk_fma_f32 v[110:111], v[98:99], v[98:99], v[104:105] neg_lo:[1,0,0] neg_hi:[1,0,0]
    v_pk_add_f32 v[102:103], v[110:111], s[54:55]
    s_cmp_eq_u32 s32, 0
    v_rsq_f32_e64 v112, |v102|
    v_rsq_f32_e64 v113, |v103|
    s_cbranch_scc1 L_z0
    v_mul_f32_dpp v106, v109, v112 row_newbcast:4 row_mask:0xf bank_mask:0xf
    v_mul_f32_dpp v107, v109, v113 row_newbcast:5 row_mask:0xf bank_mask:0xf
    v_ashrrev_i32 v118, 31, v106
    v_ashrrev_i32 v119, 31, v107
    v_bitop3_b32 v118, v106, v118, s61 bitop3:0x1e
    v_bitop3_b32 v119, v107, v119, s61 bitop3:0x1e
    v_bfi_b32 v118, s60, v89, v118
    v_bfi_b32 v119, s60, v0, v119
    v_max_u32 v119, v118, v119
    v_pk_add_f32 v[100:101], v[112:113], 1.0 op_sel_hi:[1,0]
    v_mov_b32 v118, s33
    v_max_u32_dpp v119, v119, v119 row_bcast:15 row_mask:0xa bank_mask:0xf
    v_pk_mul_f32 v[110:111], v[110:111], v[100:101]
    s_cmp_lg_u32 s3, 0
    v_max_u32_dpp v119, v119, v119 row_bcast:31 row_mask:0xc bank_mask:0xf
    s_cbranch_scc1 L_nost
    s_mov_b32 exec_lo, 0
    s_mov_b32 exec_hi, s61
    s_cmp_eq_u32 s34, 0
    s_cbranch_scc1 L_tabst_slow
    buffer_store_dwordx2 v[118:119], off, s[8:11], s45
L_tabst_back:
    s_mov_b64 exec, -1
L_nost:
    v_readlane_b32 s35, v119, 63
    v_pk_mul_f32 v[58:59], v[98:99], v[112:113]
    v_pk_fma_f32 v[110:111], v[110:111], v[100:101], s[54:55]
    s_bitcmp0_b32 s35, 8
    s_cselect_b64 vcc, -1, 0
    v_rsq_f32_e64 v110, |v110|
    v_rsq_f32_e64 v111, |v111|
    s_andn2_b32 s65, 0x600, s35
    s_lshr_b32 s65, s65, 5
    v_cndmask_b32 v102, v112, v113, vcc
    v_cndmask_b32 v103, v58, v59, vcc
    v_cndmask_b32 v120, v2, v3, vcc
    v_cndmask_b32 v121, v4, v5, vcc
    v_cndmask_b32 v122, v6, v7, vcc
    v_cndmask_b32 v123, v8, v9, vcc
    v_pk_fma_f32 v[120:121], v[120:121], v[102:103], v[102:103] op_sel:[0,0,1] op_sel_hi:[1,0,1] neg_lo:[0,0,1] neg_hi:[0,0,1]
    v_pk_fma_f32 v[122:123], v[122:123], v[102:103], v[102:103] op_sel:[0,0,1] op_sel_hi:[1,0,1] neg_lo:[0,0,1] neg_hi:[0,0,1]
    v_and_b32 v118, 0x3ff, v72
    v_mov_b32 v119, 32256
    v_cvt_pk_bf16_f32 v104, v120, v121
    v_cvt_pk_bf16_f32 v105, v122, v123
    s_bfm_b64 exec, 16, s65
    ds_write_b64 v118, v[104:105] offset:32384
    ds_write_b32 v119, v102 offset:12
    s_mov_b64 exec, -1
    s_cmp_eq_u32 s32, 2
    s_cbranch_scc1 L_tab2e
    v_pk_mul_f32 v[112:113], v[110:111], v[100:101]
L_z0:
    v_pk_mul_f32 v[114:115], v[112:113], s[56:57]
    v_pk_mul_f32 v[116:117], v[98:99], v[114:115]
    v_pk_fma_f32 v[120:121], v[2:3], v[114:115], v[116:117] neg_lo:[0,0,1] neg_hi:[0,0,1]
    v_pk_fma_f32 v[122:123], v[4:5], v[114:115], v[116:117] neg_lo:[0,0,1] neg_hi:[0,0,1]
    v_pk_fma_f32 v[124:125], v[6:7], v[114:115], v[116:117] neg_lo:[0,0,1] neg_hi:[0,0,1]
    v_pk_fma_f32 v[126:127], v[8:9], v[114:115], v[116:117] neg_lo:[0,0,1] neg_hi:[0,0,1]
    v_cvt_pk_f16_f32 v102, v120, v121
    v_cvt_pk_f16_f32 v103, v122, v123
    v_cvt_pk_f16_f32 v104, v124, v125
    v_cvt_pk_f16_f32 v105, v126, v127
    v_mfma_f32_16x16x16_f16 v[106:109], v[14:15], v[102:103], 0
    s_nop 0
    v_mfma_f32_16x16x16_f16 v[110:113], v[14:15], v[104:105], 0
    s_nop 5
    v_cvt_pk_f16_f32 v102, v106, v107
    s_nop 0
    v_cvt_pk_f16_f32 v103, v110, v111
    v_cvt_pk_f16_f32 v104, v108, v109
    v_cvt_pk_f16_f32 v105, v112, v113
    ds_write_b64 v75, v[102:103]
    ds_write_b64 v75, v[104:105] offset:1024
    s_cmp_ge_u32 s3, s32
    s_cbranch_scc1 L_ub
L_ut_r:
    s_sub_u32 s50, s50, 1
    s_cbranch_scc1 L_end
L_ut:
    buffer_load_dwordx2 v[126:127], v88, s[8:11], s46 offen sc1
    s_waitcnt vmcnt(0)
    v_cmp_ne_u32 vcc, s33, v126
    s_cbranch_vccnz L_ut_r
    v_cmp_lt_u32 vcc, s35, v127
    v_mov_b32 v126, s35
    v_lshlrev_b32 v93, 4, v92
    s_waitcnt lgkmcnt(0)
    s_barrier
    s_cbranch_vccnz L_ub2
    ds_read_b128 v[94:97], v93 offset:32384
    ds_read_b32 v127, v119 offset:12
    s_waitcnt lgkmcnt(0)
    buffer_store_dwordx4 v[94:97], v93, s[8:11], s47 offen sc1
    s_mov_b64 exec, 1
    buffer_store_dwordx2 v[126:127], off, s[8:11], s47 offset:3072 sc1
    s_mov_b64 exec, -1
    s_branch L_ub2
L_ub:
    s_waitcnt lgkmcnt(0)
    s_barrier
L_ub2:
    ds_read_b64_tr_b16 v[102:103], v76
    ds_read_b64_tr_b16 v[104:105], v76 offset:512
    ds_read_b64_tr_b16 v[106:107], v76 offset:1024
    ds_read_b64_tr_b16 v[108:109], v76 offset:1536
L_tg1:
L_tg2:
    s_waitcnt lgkmcnt(2)
    v_mfma_f32_16x16x32_f16 v[110:113], v[102:105], v[20:23], 0
    v_mfma_f32_16x16x32_f16 v[114:117], v[102:105], v[28:31], 0
    s_waitcnt lgkmcnt(0)
    v_mfma_f32_16x16x32_f16 v[110:113], v[106:109], v[24:27], v[110:113]
    v_mfma_f32_16x16x32_f16 v[114:117], v[106:109], v[20:23], v[114:117]
    s_nop 6
    v_pk_mul_f32 v[122:123], v[110:111], v[36:37]
    v_pk_mul_f32 v[118:119], v[110:111], v[32:33]
    v_pk_fma_f32 v[122:123], v[114:115], v[32:33], v[122:123] neg_lo:[0,0,1] neg_hi:[0,0,1]
    v_pk_fma_f32 v[118:119], v[114:115], v[36:37], v[118:119]
    v_pk_mul_f32 v[124:125], v[112:113], v[38:39]
    v_pk_mul_f32 v[120:121], v[112:113], v[34:35]
    v_pk_fma_f32 v[124:125], v[116:117], v[34:35], v[124:125] neg_lo:[0,0,1] neg_hi:[0,0,1]
    v_pk_fma_f32 v[120:121], v[116:117], v[38:39], v[120:121]
    v_cvt_pk_f16_f32 v102, v118, v122
    v_cvt_pk_f16_f32 v103, v119, v123
    v_cvt_pk_f16_f32 v104, v120, v124
    v_cvt_pk_f16_f32 v105, v121, v125
    s_nop 1
    v_mfma_f32_16x16x32_f16 v[110:113], v[40:43], v[102:105], 0
    v_mfma_f32_16x16x32_f16 v[114:117], v[44:47], v[102:105], 0
    s_cmp_lg_u32 s32, 0
    s_cbranch_scc1 L_tab1e
    s_nop 5
    v_cvt_pk_f16_f32 v102, v110, v114
    v_and_b32 v102, -2, v102
    buffer_store_dword v102, v77, s[8:11], s39 offen offset:0 nt
    v_cvt_pk_f16_f32 v103, v111, v115
    v_and_b32 v103, -2, v103
    buffer_store_dword v103, v77, s[8:11], s39 offen offset:128 nt
    v_cvt_pk_f16_f32 v104, v112, v116
    v_and_b32 v104, -2, v104
    buffer_store_dword v104, v77, s[8:11], s39 offen offset:256 nt
    v_cvt_pk_f16_f32 v105, v113, v117
    v_and_b32 v105, -2, v105
    buffer_store_dword v105, v77, s[8:11], s39 offen offset:384 nt
    s_branch L_flag0
L_tab1e:
    s_nop 5
    v_cvt_pk_f16_f32 v102, v110, v114
    v_or_b32 v102, 1, v102
    buffer_store_dword v102, v77, s[8:11], s39 offen offset:0 nt
    v_cvt_pk_f16_f32 v103, v111, v115
    v_or_b32 v103, 1, v103
    buffer_store_dword v103, v77, s[8:11], s39 offen offset:128 nt
    v_cvt_pk_f16_f32 v104, v112, v116
    v_or_b32 v104, 1, v104
    buffer_store_dword v104, v77, s[8:11], s39 offen offset:256 nt
    v_cvt_pk_f16_f32 v105, v113, v117
    v_or_b32 v105, 1, v105
    buffer_store_dword v105, v77, s[8:11], s39 offen offset:384 nt
    v_pk_fma_f32 v[2:3], v[2:3], v[100:101], v[58:59] neg_lo:[0,0,1] neg_hi:[0,0,1]
    v_pk_fma_f32 v[4:5], v[4:5], v[100:101], v[58:59] neg_lo:[0,0,1] neg_hi:[0,0,1]
    v_pk_fma_f32 v[6:7], v[6:7], v[100:101], v[58:59] neg_lo:[0,0,1] neg_hi:[0,0,1]
    v_pk_fma_f32 v[8:9], v[8:9], v[100:101], v[58:59] neg_lo:[0,0,1] neg_hi:[0,0,1]
    s_add_u32 s47, s47, 32768
    s_branch L_tabdone
L_tab2e:
    s_cmp_eq_u32 s3, 0
    s_waitcnt lgkmcnt(0)
    s_barrier
    s_cbranch_scc0 L_tabbar
    ds_read_b128 v[94:97], v93 offset:32384
    s_nop 0
    s_branch L_tab
L_tab_r:
    s_sub_u32 s50, s50, 1
    s_cbranch_scc1 L_end
L_tab:
    buffer_load_dwordx2 v[126:127], v88, s[8:11], s46 offen sc1
L_tabw1:
    s_waitcnt vmcnt(0)
    v_cmp_ne_u32 vcc, s33, v126
    s_cbranch_vccnz L_tab_r
L_tabok:
    v_cmp_lt_u32 s[64:65], s35, v127
    v_mov_b32 v126, 32256
    s_cmp_lg_u32 s64, 0
    s_cbranch_scc1 L_np0
    v_mov_b32 v127, s35
    s_waitcnt lgkmcnt(0)
    buffer_store_dwordx4 v[94:97], v93, s[8:11], s47 offen sc1
    s_mov_b64 exec, 1
    buffer_store_dword v127, off, s[8:11], s47 offset:3072 sc1
    s_mov_b64 exec, -1
L_np0:
    v_mov_b32 v127, s64
    ds_write_b32 v126, v127
    s_waitcnt lgkmcnt(0)
    s_barrier
    s_branch L_tabgot
L_tabbar:
    v_mov_b32 v126, 32256
    s_barrier
    ds_read_b64 v[126:127], v126
    s_waitcnt lgkmcnt(0)
    v_readfirstlane_b32 s64, v126
L_tabgot:
    s_mov_b32 s73, 64
    s_cmp_lg_u32 s64, 0
    s_cbranch_scc1 L_fin
    s_andn2_b32 s64, s60, s35
    s_lshr_b32 s73, s64, 8
    s_branch L_fin
L_flag0:
    s_mov_b32 s34, 1
    s_mov_b32 s41, 0
    s_mov_b32 s84, 0
    s_mov_b32 s35, s51
    s_mov_b32 s47, 8388608
    s_xor_b32 s76, s27, 9
    s_or_b32 s76, s76, s3
    s_mov_b32 s53, 64
    s_lshl_b32 s64, s27, 3
    s_add_u32 s45, s46, s64
    v_mov_b32 v125, s35
    s_waitcnt vmcnt(0)
    v_add_u32 v124, 1, v70
    s_cmp_eq_u32 s3, 0
    s_barrier
    s_cbranch_scc0 L_flag1
    s_mov_b64 exec, 1
    buffer_store_dwordx2 v[124:125], off, s[8:11], s45
    s_mov_b64 exec, -1
    v_mov_b32 v123, 32256
    ds_write_b32 v123, v124 offset:4
    v_readfirstlane_b32 s33, v124
L_flag1:
    v_lshlrev_b32 v93, 4, v92
    v_mov_b32 v67, 0x3f803f80
    v_dot2_f32_bf16 v66, v10, v67, 0
    v_dot2_f32_bf16 v66, v11, v67, v66
    v_dot2_f32_bf16 v66, v12, v67, v66
    v_dot2_f32_bf16 v66, v13, v67, v66
    v_lshlrev_b32 v10, 16, v62
    v_and_b32 v11, 0xffff0000, v62
    v_lshlrev_b32 v12, 16, v63
    v_add_f32_dpp v66, v66, v66 row_ror:8 row_mask:0xf bank_mask:0xf
    v_and_b32 v13, 0xffff0000, v63
    v_mul_f32 v10, 0x44000000, v10
    v_add_f32_dpp v66, v66, v66 row_ror:4 row_mask:0xf bank_mask:0xf
    v_mul_f32 v11, 0x44000000, v11
    v_mul_f32 v12, 0x44000000, v12
    v_add_f32_dpp v66, v66, v66 row_ror:2 row_mask:0xf bank_mask:0xf
    v_mul_f32 v13, 0x44000000, v13
    s_nop 0
    v_add_f32_dpp v66, v66, v66 row_ror:1 row_mask:0xf bank_mask:0xf
    s_nop 1
    v_add_f32_dpp v66, v66, v66 row_bcast:15 row_mask:0xa bank_mask:0xf
    s_nop 1
    v_add_f32_dpp v66, v66, v66 row_bcast:31 row_mask:0xc bank_mask:0xf
    s_nop 0
    v_readlane_b32 s64, v66, 63
    s_nop 1
    v_subrev_f32 v10, s64, v10
    v_subrev_f32 v11, s64, v11
    v_subrev_f32 v12, s64, v12
    v_subrev_f32 v13, s64, v13
    v_mov_b32 v123, 32256
    s_cmp_lg_u32 s3, 0
    s_cbranch_scc1 L_t0b
    s_branch L_t0
L_t0_r:
    s_sub_u32 s53, s53, 1
    s_cbranch_scc1 L_tab2
L_t0:
    buffer_load_dwordx2 v[126:127], v88, s[8:11], s46 offen sc1
    s_waitcnt vmcnt(0)
    v_cmp_ne_u32 vcc, s33, v126
    s_cbranch_vccnz L_t0_r
L_t0ok:
    v_cmp_ne_u32 vcc, s35, v127
    s_nop 1
    v_mov_b32 v127, vcc_lo
    ds_write_b32 v123, v127
    s_waitcnt lgkmcnt(0)
L_t0b:
    s_cmp_lt_u32 s27, 8
    s_barrier
    buffer_load_dwordx4 v[110:113], v78, s[8:11], s40 offen sc1
    s_cbranch_scc0 L_t0c
    buffer_load_dwordx4 v[114:117], v79, s[8:11], s40 offen sc1
L_t0c:
    ds_read_b64 v[126:127], v123
    s_waitcnt lgkmcnt(0)
    v_readfirstlane_b32 s64, v126
    v_readfirstlane_b32 s33, v127
    s_cmp_eq_u32 s64, 0
    s_cselect_b32 s34, 1, 0
    s_nop 1
    s_cbranch_scc0 L_slow
    s_cmp_lt_u32 s27, 8
    s_cbranch_scc0 L_yw
    s_branch L_yselfw
L_tabdone:
    s_cmp_eq_u32 s34, 0
    s_cbranch_scc1 L_slow
L_slowback:
    s_cmp_lt_u32 s27, 8
    s_cbranch_scc0 L_y
    s_branch L_yself
L_y_r:
    s_sub_u32 s50, s50, 1
    s_cbranch_scc1 L_end
    s_mov_b64 exec, vcc
    s_sleep 1
L_y:
    buffer_load_dwordx4 v[110:113], v78, s[8:11], s40 offen sc1
    s_mov_b64 exec, -1
L_yw:
    s_waitcnt vmcnt(0)
    ds_write_b128 v80, v[110:113]
    v_bitop3_b32 v118, v110, v111, s41 bitop3:0x7e
    v_bitop3_b32 v118, v118, v112, s41 bitop3:0xf6
    v_bitop3_b32 v118, v118, v113, s41 bitop3:0xf6
    v_and_b32 v118, 1, v118
    v_cmp_ne_u32 vcc, 0, v118
    s_cbranch_vccnz L_y_r
L_yjoin:
    s_cmp_eq_u32 s76, 0
    s_cbranch_scc1 L_xf
L_noxf:
    s_waitcnt lgkmcnt(0)
    s_barrier
    ds_read_b64_tr_b16 v[102:103], v81
    ds_read_b64_tr_b16 v[104:105], v81 offset:4608
    s_add_u32 s46, s46, 2048
    s_add_u32 s45, s45, 2048
    s_cmp_eq_u32 s26, 0
    s_cbranch_scc1 L_y0
    s_waitcnt lgkmcnt(0)
    v_mfma_f32_16x16x32_f16 v[110:113], v[102:105], v[48:51], 0
    v_mfma_f32_16x16x32_f16 v[114:117], v[102:105], v[52:55], 0
    s_nop 7
    v_pk_add_f32 v[110:111], v[110:111], v[114:115] op_sel:[0,1] op_sel_hi:[1,0] neg_hi:[0,1]
    v_pk_add_f32 v[112:113], v[112:113], v[116:117] op_sel:[0,1] op_sel_hi:[1,0] neg_hi:[0,1]
L_y0b:
    v_cvt_pk_f16_f32 v102, v110, v111
    v_cvt_pk_f16_f32 v103, v112, v113
    ds_write_b64 v82, v[102:103]
    s_waitcnt lgkmcnt(0)
    s_barrier
    ds_read_b128 v[106:109], v83
    s_cmp_lg_u32 s32, 0
    s_cbranch_scc1 L_hdr
    s_waitcnt lgkmcnt(0)
    buffer_store_dwordx4 v[106:109], v84, s[8:11], s43 offen sc1
    v_mov_b32 v94, -1
    v_mov_b32 v95, -1
    v_mov_b32 v96, -1
    v_mov_b32 v97, -1
    s_mov_b32 s78, 3604480
    buffer_store_dwordx4 v[94:97], v84, s[8:11], s78 offen sc1
    v_and_b32 v126, 7, v92
    v_lshlrev_b32 v126, 7, v126
    s_mov_b32 s74, 4096
    v_mov_b32 v122, s33
    s_mov_b64 exec, 0xff
    buffer_load_dword v122, v126, s[8:11], s74 offen sc1
    s_mov_b64 exec, -1
L_nxl:
    s_and_b32 s64, s4, 3
    s_lshr_b32 s65, s3, 2
    s_bfe_u32 s66, s4, 0x10002
    s_mov_b32 s58, 0x41800000
    s_cmp_eq_u32 s64, 0
    s_cselect_b32 s36, s65, s66
    s_cselect_b32 s58, 0x41000000, s58
    s_cselect_b32 s38, 0x3e000000, s56
    s_cselect_b32 s67, -4, 0
    s_mov_b32 s59, s58
    s_sub_u32 s68, 256, s4
    s_and_b32 s68, s68, 255
    s_cmp_eq_u32 s36, 0
    s_cselect_b32 s68, s4, s68
    s_cselect_b32 s69, 16, -16
    s_cselect_b32 s70, 0, 2036
    s_cselect_b32 s71, 1.0, -1.0
    s_add_u32 s67, s67, s70
    s_mul_i32 s70, s69, s3
    s_lshl_b32 s70, s70, 4
    s_add_u32 s67, s67, s70
    s_and_b32 s70, s68, 0x78
    s_lshl_b32 s70, s70, 8
    s_add_u32 s67, s67, s70
    s_add_u32 s70, s68, 3
    s_and_b32 s70, s70, 3
    s_lshl_b32 s70, s70, 15
    s_add_u32 s67, s67, s70
    s_and_b32 s70, s68, 4
    s_lshl_b32 s70, s70, 8
    s_add_u32 s67, s67, s70
    v_mul_i32_i24 v85, s69, v90
    v_mul_u32_u24 v114, 131840, v91
    v_add3_u32 v85, v85, v114, s67
    v_lshrrev_b32 v114, 1, v90
    v_and_b32 v114, 6, v114
    v_and_or_b32 v114, v90, 1, v114
    v_lshl_add_u32 v56, v114, 8, s4
    v_cvt_f32_u32 v114, v56
    v_cvt_f32_u32 v115, v91
    v_mul_f32 v114, 0x3a000000, v114
    v_mul_f32 v114, s71, v114
    v_mul_f32 v115, v114, v115
    v_fma_f32 v116, v114, 4.0, v115
    v_cos_f32 v117, v115
    v_sin_f32 v118, v115
    v_cos_f32 v119, v116
    v_sin_f32 v120, v116
    v_bfe_u32 v114, v90, 1, 1
    v_cmp_eq_u32 vcc, s36, v114
    v_cvt_pk_f16_f32 v117, v117, v118
    s_lshr_b32 s70, s68, 3
    s_and_b32 s70, s70, 16
    s_lshl_b32 s70, 0x3c00, s70
    s_mov_b64 exec, 0xffff
    v_mov_b32 v117, s70
    s_mov_b64 exec, -1
    v_cvt_pk_f16_f32 v119, v119, v120
    v_cndmask_b32 v16, 0, v117, vcc
    v_cndmask_b32 v17, v117, 0, vcc
    v_cndmask_b32 v18, 0, v119, vcc
    v_cndmask_b32 v19, v119, 0, vcc
    v_and_b32 v114, 0x1cf, v0
    v_cmp_eq_u32 vcc, 0, v114
    v_mov_b32 v115, s58
    s_sub_u32 s64, 2047, s4
    v_lshlrev_b32 v89, 9, v91
    v_cndmask_b32 v86, v115, 0, vcc
    v_cndmask_b32 v87, v115, 0, vcc
    v_sub_u32 v89, s64, v89
    v_add_u32 v0, 0xffffff00, v89
    s_lshl_b32 s47, s26, 12
    s_add_u32 s47, s47, 65536
L_tg0w:
    s_waitcnt vmcnt(0)
L_tg0c:
    v_cmp_ne_u32 vcc, s33, v122
    s_cbranch_vccnz L_tg0_r
    s_branch L_g
L_g_r:
    s_sub_u32 s50, s50, 1
    s_cbranch_scc1 L_end
    s_mov_b64 exec, vcc
    s_sleep 2
L_g:
    buffer_load_dwordx4 v[102:105], v85, s[8:11], s43 offen sc1
    buffer_load_dwordx4 v[106:109], v85, s[8:11], s44 offen sc1
    s_mov_b64 exec, -1
L_gw:
    s_cmp_lg_u32 s36, 0
    s_cbranch_scc1 L_xmir0
    s_waitcnt vmcnt(0)
L_xdir:
    v_mfma_f32_16x16x16_f16 v[110:113], v[16:17], v[102:103], 0
    v_mfma_f32_16x16x16_f16 v[114:117], v[16:17], v[104:105], 0
    v_mfma_f32_16x16x16_f16 v[110:113], v[18:19], v[106:107], v[110:113]
    v_mfma_f32_16x16x16_f16 v[114:117], v[18:19], v[108:109], v[114:117]
    s_branch L_xjoin
L_xmir0:
    s_waitcnt vmcnt(0)
L_xmir:
    v_mfma_f32_16x16x16_f16 v[110:113], v[16:17], v[104:105], 0
    v_mfma_f32_16x16x16_f16 v[114:117], v[16:17], v[102:103], 0
    v_mfma_f32_16x16x16_f16 v[110:113], v[18:19], v[108:109], v[110:113]
    v_mfma_f32_16x16x16_f16 v[114:117], v[18:19], v[106:107], v[114:117]
L_xjoin:
    v_max3_u32 v118, v102, v103, v104
    v_max3_u32 v118, v118, v105, v106
    v_max3_u32 v118, v118, v107, v108
    v_max_u32 v118, v118, v109
    v_cmp_eq_u32 vcc, -1, v118
    s_cbranch_vccnz L_g_r
    s_mov_b32 s32, 1
    s_mov_b32 s41, -1
    s_add_u32 s43, s43, 1114112
    s_add_u32 s44, s44, 1114112
L_apply:
    s_cmp_eq_u32 s84, 0
    v_pk_fma_f32 v[2:3], v[110:111], v[86:87], v[2:3]
    v_pk_fma_f32 v[4:5], v[112:113], s[58:59], v[4:5]
    v_pk_fma_f32 v[6:7], v[114:115], s[58:59], v[6:7]
    v_pk_fma_f32 v[8:9], v[116:117], s[58:59], v[8:9]
    s_cbranch_scc1 L_top
    s_branch L_corr
L_xf:
    s_lshl_b32 s76, s26, 7
    s_add_u32 s76, s76, 4096
    v_lshrrev_b32 v118, 1, v88
    v_mov_b32 v119, s33
    s_mov_b32 exec_hi, 0
    buffer_store_dword v119, v118, s[8:11], s76 offen sc1
    s_mov_b64 exec, -1
    s_branch L_noxf
L_y0:
    s_waitcnt lgkmcnt(0)
    v_mfma_f32_16x16x32_f16 v[110:113], v[102:105], v[48:51], 0
    v_xor_b32 v106, s61, v102
    v_xor_b32 v107, s61, v103
    v_mfma_f32_16x16x32_f16 v[114:117], v[102:105], v[52:55], 0
    v_xor_b32 v108, s61, v104
    v_xor_b32 v109, s61, v105
    s_nop 1
    v_mfma_f32_16x16x32_f16 v[118:121], v[106:109], v[48:51], 0
    v_mfma_f32_16x16x32_f16 v[122:125], v[106:109], v[52:55], 0
    s_nop 1
    v_add_f32 v110, v110, v115
    v_add_f32 v112, v112, v117
    s_nop 3
    v_add_f32 v111, v118, v123
    v_add_f32 v113, v120, v125
    s_nop 0
    s_branch L_y0b
L_yself_r:
    s_sub_u32 s50, s50, 1
    s_cbranch_scc1 L_end
    s_mov_b64 exec, vcc
    s_sleep 1
L_yself:
    buffer_load_dwordx4 v[110:113], v78, s[8:11], s40 offen sc1
    buffer_load_dwordx4 v[114:117], v79, s[8:11], s40 offen sc1
    s_mov_b64 exec, -1
L_yselfw:
    s_bitcmp1_b32 s3, 0
    s_cbranch_scc1 L_yself4
    s_waitcnt vmcnt(0)
    v_pk_add_f16 v106, v110, v117 neg_hi:[0,1]
    v_pk_add_f16 v107, v111, v116 neg_hi:[0,1]
    v_pk_add_f16 v108, v112, v115 neg_hi:[0,1]
    v_pk_add_f16 v109, v113, v114 neg_hi:[0,1]
    ds_write_b128 v80, v[106:109]
    s_branch L_yselfc
L_yself4:
    s_waitcnt vmcnt(0)
    v_pk_add_f16 v106, v110, v117 op_sel:[1,1] op_sel_hi:[0,0] neg_hi:[1,0]
    v_pk_add_f16 v107, v111, v116 op_sel:[1,1] op_sel_hi:[0,0] neg_hi:[1,0]
    v_pk_add_f16 v108, v112, v115 op_sel:[1,1] op_sel_hi:[0,0] neg_hi:[1,0]
    v_pk_add_f16 v109, v113, v114 op_sel:[1,1] op_sel_hi:[0,0] neg_hi:[1,0]
    ds_write_b128 v80, v[106:109]
L_yselfc:
    v_bitop3_b32 v118, v110, v111, s41 bitop3:0x7e
    v_bitop3_b32 v118, v118, v112, s41 bitop3:0xf6
    v_bitop3_b32 v118, v118, v113, s41 bitop3:0xf6
    v_bitop3_b32 v118, v118, v114, s41 bitop3:0xf6
    v_bitop3_b32 v118, v118, v115, s41 bitop3:0xf6
    v_bitop3_b32 v118, v118, v116, s41 bitop3:0xf6
    v_bitop3_b32 v118, v118, v117, s41 bitop3:0xf6
    v_and_b32 v118, 1, v118
    v_cmp_ne_u32 vcc, 0, v118
    s_cbranch_vccnz L_yself_r
    s_branch L_yjoin
L_hdr:
    s_waitcnt lgkmcnt(0)
    buffer_store_dwordx4 v[106:109], v84, s[8:11], s43 offen sc1
    v_and_b32 v67, 0x3ff, v72
    v_mov_b32 v126, v67
    v_lshlrev_b32 v119, 4, v92
    v_mov_b32 v120, 0x3f80
    v_and_b32 v119, 16, v119
    v_lshlrev_b32 v120, v119, v120
    v_and_b32 v119, 2, v92
    v_cmp_eq_u32 vcc, 0, v119
    v_lshl_add_u32 v67, v91, 10, v67
    s_lshl_b32 s67, s3, 8
    v_cndmask_b32 v68, 0, v120, vcc
    v_cndmask_b32 v69, v120, 0, vcc
    s_add_u32 s67, s67, 28160
    v_lshl_add_u32 v71, v90, 4, s67
    v_and_b32 v119, 1, v91
    v_lshl_add_u32 v71, v119, 11, v71
    v_add_u32 v70, 28160, v77
    s_mov_b32 s86, 32768
    s_lshl_b32 s87, s26, 8
    s_add_u32 s87, s87, 20480
    s_lshl_b32 s85, s3, 30
    s_and_b32 s85, s85, s61
    s_xor_b32 s85, s85, s38
    s_mov_b32 s84, 2
    s_lshl_b32 s64, s27, 3
    v_mov_b32 v110, s64
L_ywait:
    v_mov_b32 v111, 32256
    s_cmp_lg_u32 s3, 0
    s_cbranch_scc1 L_hintb
L_hint_r:
    s_sub_u32 s50, s50, 1
    s_cbranch_scc1 L_end
    s_sleep 1
L_hint:
    buffer_load_dwordx2 v[112:113], v110, s[8:11], s87 offen sc1
    s_waitcnt vmcnt(0)
    v_cmp_ne_u32 vcc, s33, v112
    s_cbranch_vccnz L_hint_r
    ds_write_b32 v111, v113 offset:8
    s_waitcnt lgkmcnt(0)
L_hintb:
    s_barrier
    ds_read_b32 v113, v111 offset:8
    s_cmp_eq_u32 s32, 2
    s_cbranch_scc1 L_yv3
    buffer_load_dwordx4 v[102:105], v85, s[8:11], s43 offen sc1
    buffer_load_dwordx4 v[106:109], v85, s[8:11], s44 offen sc1
    s_add_u32 s72, s86, 4096
    s_waitcnt lgkmcnt(0)
    v_readfirstlane_b32 s75, v113
    s_nop 0
    s_andn2_b32 s75, s60, s75
    s_and_b32 s74, s75, 15
    s_sub_u32 s65, 16, s74
    s_min_u32 s74, s74, s65
    s_and_b32 s74, s74, 7
    s_lshl_b32 s74, s74, 12
    s_add_u32 s74, s74, 65536
    buffer_load_dwordx2 v[62:63], v126, s[8:11], s74 offen sc1
    buffer_load_dword v64, off, s[8:11], s74 offset:3076 sc1
    v_mul_u32_u24 v119, s75, v56
    v_and_b32 v119, 0x7ff, v119
    v_cvt_f32_u32 v119, v119
    v_mul_f32 v119, 0x3a000000, v119
    v_cos_f32 v120, v119
    v_sin_f32 v121, v119
    v_and_b32 v119, 0x22, v92
    v_cvt_pk_f16_f32 v120, v120, v121
    s_and_b32 s65, s5, s61
    v_xor_b32 v120, s65, v120
    v_cmp_eq_u32 vcc, 0, v119
    v_cmp_eq_u32 s[66:67], 2, v119
    s_nop 0
    v_cndmask_b32 v56, 0, v120, vcc
    v_cndmask_b32 v57, 0, v120, s[66:67]
    s_sub_u32 s64, 2047, s75
    s_add_u32 s65, s64, 256
    v_cmp_eq_u32 vcc, s64, v89
    v_cmp_eq_u32 s[66:67], s65, v89
    s_nop 0
    v_cndmask_b32 v58, 0, 1.0, vcc
    v_cndmask_b32 v59, 0, 1.0, s[66:67]
    buffer_load_dwordx2 v[122:123], v67, s[8:11], s86 offen sc1
    buffer_load_dwordx2 v[124:125], v67, s[8:11], s72 offen sc1
    s_cmp_lg_u32 s36, 0
    s_waitcnt vmcnt(4)
    s_cbranch_scc1 L_xmir
    s_branch L_xdir
L_corr:
    s_mov_b32 s32, 2
    s_mov_b32 s84, 0
    s_waitcnt vmcnt(2)
L_basew:
    v_max3_u32 v119, v62, v63, v64
    v_cmp_eq_u32 vcc, -1, v119
    s_cbranch_vccnz L_base_r
    v_add_f32 v65, 1.0, v64
    v_rcp_f32 v65, v65
    v_lshlrev_b32 v60, 16, v62
    v_and_b32 v61, 0xffff0000, v62
    v_lshlrev_b32 v62, 16, v63
    v_and_b32 v63, 0xffff0000, v63
    v_mul_f32 v64, s56, v64
    v_cmp_eq_u32 vcc, 0, v91
    v_mul_f32 v65, v64, v65
    v_pk_mul_f32 v[60:61], v[60:61], s[56:57]
    v_pk_mul_f32 v[62:63], v[62:63], s[56:57]
    v_mul_f32 v66, v65, v65
    v_mul_f32 v66, s54, v66
    v_cndmask_b32 v65, 0, v65, vcc
    s_nop 0
    s_branch L_yc
L_yv3:
    s_add_u32 s72, s86, 4096
    s_waitcnt lgkmcnt(0)
    v_readfirstlane_b32 s75, v113
    s_mov_b32 s32, 3
    s_cmp_lg_u32 s75, s35
    s_nop 1
    s_cbranch_scc1 L_fin5
    s_branch L_yv
L_yv_r:
    s_sub_u32 s50, s50, 1
    s_cbranch_scc1 L_end
    s_mov_b64 exec, vcc
    s_sleep 1
L_yv:
    buffer_load_dwordx2 v[122:123], v67, s[8:11], s86 offen sc1
    buffer_load_dwordx2 v[124:125], v67, s[8:11], s72 offen sc1
    s_mov_b64 exec, -1
L_yc:
    s_waitcnt vmcnt(0)
    v_mfma_f32_16x16x16_bf16 v[110:113], v[68:69], v[122:123], 0
    v_mfma_f32_16x16x16_bf16 v[110:113], v[68:69], v[124:125], v[110:113]
    v_max3_u32 v119, v122, v123, v124
    v_max_u32 v119, v119, v125
    v_cmp_eq_u32 vcc, -1, v119
    s_cbranch_vccnz L_yv_r
    s_cmp_eq_u32 s32, 3
    s_nop 1
    s_cbranch_scc1 L_fin3
L_pass:
    v_pk_fma_f32 v[114:115], v[110:111], v[64:65], v[60:61] op_sel:[0,1,0]
    v_pk_fma_f32 v[116:117], v[112:113], v[64:65], v[62:63] op_sel:[0,1,0]
    v_cvt_pk_f16_f32 v114, v114, v115
    v_cvt_pk_f16_f32 v115, v116, v117
    ds_write_b64 v75, v[114:115]
    v_pk_fma_f32 v[2:3], v[58:59], v[110:111], v[2:3] op_sel:[0,0,0] op_sel_hi:[1,0,1]
    v_pk_fma_f32 v[4:5], v[58:59], v[110:111], v[4:5] op_sel:[0,1,0] op_sel_hi:[1,1,1]
    v_pk_fma_f32 v[6:7], v[58:59], v[112:113], v[6:7] op_sel:[0,0,0] op_sel_hi:[1,0,1]
    v_pk_fma_f32 v[8:9], v[58:59], v[112:113], v[8:9] op_sel:[0,1,0] op_sel_hi:[1,1,1]
    s_cmp_gt_u32 s3, 3
    s_waitcnt lgkmcnt(0)
    s_barrier
    s_cbranch_scc1 L_dhb
L_pf:
    ds_read_b64_tr_b16 v[110:111], v76
    ds_read_b64_tr_b16 v[112:113], v76 offset:512
    v_mov_b32 v124, 0x3c003c00
    s_waitcnt lgkmcnt(0)
    v_mfma_f32_16x16x32_f16 v[114:117], v[110:113], v[20:23], 0
    v_mfma_f32_16x16x32_f16 v[118:121], v[110:113], v[28:31], 0
    v_dot2_f32_f16 v122, v110, v124, 0
    v_dot2_f32_f16 v123, v110, v110, 0
    v_dot2_f32_f16 v122, v111, v124, v122
    v_dot2_f32_f16 v123, v111, v111, v123
    v_dot2_f32_f16 v122, v112, v124, v122
    v_dot2_f32_f16 v123, v112, v112, v123
    v_dot2_f32_f16 v122, v113, v124, v122
    v_dot2_f32_f16 v123, v113, v113, v123
    v_pk_mul_f32 v[52:53], v[114:115], v[36:37]
    v_pk_mul_f32 v[54:55], v[116:117], v[38:39]
    v_pk_mul_f32 v[48:49], v[118:119], v[36:37]
    v_permlane32_swap_b32 v122, v123
    v_pk_mul_f32 v[50:51], v[120:121], v[38:39]
    v_add_f32 v122, v122, v123
    v_pk_fma_f32 v[48:49], v[114:115], v[32:33], v[48:49]
    v_pk_fma_f32 v[52:53], v[118:119], v[32:33], v[52:53] neg_lo:[0,0,1] neg_hi:[0,0,1]
    v_add_f32_dpp v122, v122, v122 row_ror:8 row_mask:0xf bank_mask:0xf
    v_pk_fma_f32 v[50:51], v[116:117], v[34:35], v[50:51]
    v_pk_fma_f32 v[54:55], v[120:121], v[34:35], v[54:55] neg_lo:[0,0,1] neg_hi:[0,0,1]
    v_add_f32_dpp v122, v122, v122 row_ror:4 row_mask:0xf bank_mask:0xf
    v_cvt_pk_f16_f32 v94, v48, v52
    v_cvt_pk_f16_f32 v95, v49, v53
    v_add_f32_dpp v122, v122, v122 row_ror:2 row_mask:0xf bank_mask:0xf
    v_cvt_pk_f16_f32 v96, v50, v54
    v_cvt_pk_f16_f32 v97, v51, v55
    v_add_f32_dpp v122, v122, v122 row_ror:1 row_mask:0xf bank_mask:0xf
    s_nop 0
    v_mfma_f32_16x16x32_f16 v[114:117], v[40:43], v[94:97], 0
    v_mfma_f32_16x16x32_f16 v[118:121], v[44:47], v[94:97], 0
    v_add_f32_dpp v122, v122, v122 row_bcast:15 row_mask:0xa bank_mask:0xf
    v_mul_f32 v122, s52, v122
    s_nop 0
    v_readlane_b32 s66, v122, 63
    v_readlane_b32 s65, v122, 31
    s_nop 0
    v_add_f32 v123, s66, v66
    v_mov_b32 v122, s65
    v_fma_f32 v122, -v122, v122, v123
    v_rsq_f32_e64 v122, |v122|
    s_nop 0
    v_mul_f32 v122, s85, v122
    v_pk_mul_f32 v[114:115], v[114:115], v[122:123] op_sel_hi:[1,0]
    v_pk_mul_f32 v[116:117], v[116:117], v[122:123] op_sel_hi:[1,0]
    v_pk_mul_f32 v[118:119], v[118:119], v[122:123] op_sel_hi:[1,0]
    v_pk_mul_f32 v[120:121], v[120:121], v[122:123] op_sel_hi:[1,0]
    v_cvt_pk_f16_f32 v94, v114, v118
    v_cvt_pk_f16_f32 v95, v115, v119
    v_cvt_pk_f16_f32 v96, v116, v120
    v_cvt_pk_f16_f32 v97, v117, v121
    ds_write2_b32 v70, v94, v95 offset0:0 offset1:32
    ds_write2_b32 v70, v96, v97 offset0:64 offset1:96
    s_waitcnt lgkmcnt(0)
L_dhb:
    s_barrier
    ds_read_b128 v[118:121], v71
    s_waitcnt lgkmcnt(0)
    v_mfma_f32_16x16x16_f16 v[110:113], v[56:57], v[118:119], 0
    v_mfma_f32_16x16x16_f16 v[114:117], v[56:57], v[120:121], 0
    s_nop 4
    s_branch L_apply
L_fin:
    v_pk_fma_f32 v[2:3], v[2:3], v[100:101], v[58:59] neg_lo:[0,0,1] neg_hi:[0,0,1]
    v_pk_fma_f32 v[4:5], v[4:5], v[100:101], v[58:59] neg_lo:[0,0,1] neg_hi:[0,0,1]
    v_pk_fma_f32 v[6:7], v[6:7], v[100:101], v[58:59] neg_lo:[0,0,1] neg_hi:[0,0,1]
    v_pk_fma_f32 v[8:9], v[8:9], v[100:101], v[58:59] neg_lo:[0,0,1] neg_hi:[0,0,1]
    v_cvt_pk_bf16_f32 v102, v2, v4
    v_cvt_pk_bf16_f32 v103, v6, v8
    v_cvt_pk_bf16_f32 v104, v3, v5
    v_cvt_pk_bf16_f32 v105, v7, v9
    v_lshlrev_b32 v118, 1, v91
    v_mov_b32 v121, 0x200000
    s_sub_u32 s64, s73, 1
    v_cmp_eq_u32 vcc, s73, v118
    v_cmp_eq_u32 s[66:67], s64, v118
    s_nop 0
    v_cndmask_b32 v119, v72, v121, vcc
    v_cndmask_b32 v120, v72, v121, s[66:67]
    buffer_store_dwordx2 v[102:103], v72, s[28:31], s48 offen sc1
    buffer_store_dwordx2 v[104:105], v72, s[28:31], s49 offen sc1
    v_cndmask_b32 v126, v121, v72, vcc
    v_cndmask_b32 v127, v121, v72, s[66:67]
    s_or_b32 s64, s2, s3
    s_cbranch_scc1 L_fin2
    v_mov_b32 v122, s33
    buffer_store_dword v122, off, s[8:11], 0 sc1
L_fin2:
    s_cmp_eq_u32 s73, 64
    s_cbranch_scc1 L_fin5
    s_andn2_b32 s75, s60, s35
    s_add_u32 s86, s86, 8192
    s_add_u32 s87, s87, 2048
    v_mov_b32 v110, v88
    s_sub_u32 s64, 2047, s75
    s_add_u32 s65, s64, 256
    v_cmp_eq_u32 vcc, s64, v89
    v_cmp_eq_u32 s[66:67], s65, v89
    s_nop 0
    v_cndmask_b32 v58, 0, 1.0, vcc
    v_cndmask_b32 v59, 0, 1.0, s[66:67]
    s_nop 0
    s_branch L_ywait
L_fin3:
    v_pk_fma_f32 v[2:3], v[58:59], v[110:111], v[2:3] op_sel:[0,0,0] op_sel_hi:[1,0,1]
    v_pk_fma_f32 v[4:5], v[58:59], v[110:111], v[4:5] op_sel:[0,1,0] op_sel_hi:[1,1,1]
    v_pk_fma_f32 v[6:7], v[58:59], v[112:113], v[6:7] op_sel:[0,0,0] op_sel_hi:[1,0,1]
    v_pk_fma_f32 v[8:9], v[58:59], v[112:113], v[8:9] op_sel:[0,1,0] op_sel_hi:[1,1,1]
    v_cvt_pk_bf16_f32 v102, v2, v4
    v_cvt_pk_bf16_f32 v103, v6, v8
    v_cvt_pk_bf16_f32 v104, v3, v5
    v_cvt_pk_bf16_f32 v105, v7, v9
L_fin4:
    buffer_store_dwordx2 v[102:103], v126, s[28:31], s48 offen nt
    buffer_store_dwordx2 v[104:105], v127, s[28:31], s49 offen nt
L_fin5:
    s_endpgm
L_base_r:
    s_sub_u32 s50, s50, 1
    s_cbranch_scc1 L_end
    s_sleep 2
    buffer_load_dwordx2 v[62:63], v126, s[8:11], s74 offen sc1
    buffer_load_dword v64, off, s[8:11], s74 offset:3076 sc1
    s_waitcnt vmcnt(0)
    s_branch L_basew
L_tabst_slow:
    buffer_store_dwordx2 v[118:119], off, s[8:11], s45 sc1
    s_branch L_tabst_back
L_tg0_r:
    s_sub_u32 s50, s50, 1
    s_cbranch_scc1 L_end
    s_sleep 2
    s_mov_b64 exec, 0xff
    buffer_load_dword v122, v126, s[8:11], s74 offen sc1
    s_mov_b64 exec, -1
    s_branch L_tg0w
L_tab2:
    v_mov_b32 v106, s33
    v_mov_b32 v107, s51
    s_add_u32 s64, s45, 6144
    buffer_store_dwordx2 v[106:107], off, s[8:11], s64 sc1
    s_add_u32 s65, s46, 6144
L_tab2p_r:
    s_sub_u32 s50, s50, 1
    s_cbranch_scc1 L_end
    s_sleep 4
L_tab2p:
    buffer_load_dwordx2 v[126:127], v88, s[8:11], s46 offen sc1
    buffer_load_dwordx2 v[108:109], v88, s[8:11], s65 offen sc1
    s_waitcnt vmcnt(0)
    v_cmp_eq_u32 vcc, s33, v126
    s_nop 1
    v_cndmask_b32 v126, v108, v126, vcc
    v_cndmask_b32 v127, v109, v127, vcc
    v_cmp_ne_u32 vcc, s33, v126
    s_cbranch_vccnz L_tab2p_r
    s_branch L_t0ok
L_slow:
    s_cmp_lg_u32 s32, 0
    s_cbranch_scc1 L_slow1
    v_mov_b32 v106, s33
    v_mov_b32 v107, s51
    s_add_u32 s64, s45, 6144
    buffer_store_dwordx2 v[106:107], off, s[8:11], s64 sc1
L_slow1:
    buffer_store_dword v102, v77, s[8:11], s39 offen offset:0 sc1
    buffer_store_dword v103, v77, s[8:11], s39 offen offset:128 sc1
    buffer_store_dword v104, v77, s[8:11], s39 offen offset:256 sc1
    buffer_store_dword v105, v77, s[8:11], s39 offen offset:384 sc1
    s_waitcnt vmcnt(0)
    s_barrier
    s_add_u32 s64, s45, 8192
    s_add_u32 s65, s46, 8192
    v_mov_b32 v106, s33
    s_cmp_lg_u32 s3, 0
    s_cbranch_scc1 L_slowp
    buffer_store_dword v106, off, s[8:11], s64 sc1
L_slowp_r:
    s_sub_u32 s50, s50, 1
    s_cbranch_scc1 L_end
    s_sleep 2
L_slowp:
    buffer_load_dword v107, v88, s[8:11], s65 offen sc1
    s_waitcnt vmcnt(0)
    v_cmp_ne_u32 vcc, s33, v107
    s_cbranch_vccnz L_slowp_r
    s_branch L_slowback
L_ffn:
    s_and_b32 s27, s27, 31
    s_min_u32 s66, s27, 27
    s_and_b32 s64, s66, 3
    s_lshl_b32 s72, s64, 8
    s_mul_i32 s73, s64, 1792
    s_mul_i32 s64, s64, 458752
    s_mul_i32 s65, s26, 448
    s_add_u32 s64, s64, s65
    s_lshr_b32 s66, s66, 2
    s_lshl_b32 s67, s66, 6
    s_add_u32 s64, s64, s67
    v_lshrrev_b32 v43, 2, v0
    v_mul_u32_u24 v40, 3584, v43
    v_and_b32 v44, 3, v0
    v_lshl_add_u32 v40, v44, 4, v40
    v_add_u32 v40, s64, v40
    s_mul_i32 s64, s26, 229376
    s_lshl_b32 s65, s27, 5
    s_add_u32 s64, s64, s65
    v_lshrrev_b32 v41, 1, v0
    v_min_u32 v41, 223, v41
    v_lshlrev_b32 v41, 10, v41
    v_and_b32 v42, 1, v0
    v_lshl_add_u32 v41, v42, 4, v41
    v_add_u32 v41, s64, v41
    s_add_u32 s74, s46, 16384
    s_waitcnt lgkmcnt(0)
    global_load_dwordx4 v[110:113], v40, s[18:19]
    v_mov_b32 v126, v40
    global_load_dwordx4 v[114:117], v40, s[20:21]
    v_mov_b32 v125, v41
    s_mul_i32 s64, s26, 224
    s_mul_i32 s65, s27, 7
    s_add_u32 s64, s64, s65
    s_min_u32 s65, s3, 6
    s_add_u32 s64, s64, s65
    s_lshl_b32 s64, s64, 10
    v_lshl_add_u32 v127, v92, 4, s64
    s_load_dword s33, s[8:9], 0
    s_cmp_eq_u32 s3, 0
    s_cselect_b32 s64, s74, s10
    buffer_load_dword v123, v88, s[8:11], s64 offen sc1
    v_mul_u32_u24 v124, 4160, v44
    v_lshl_add_u32 v124, v43, 5, v124
    v_lshlrev_b32 v45, 4, v90
    s_and_b32 s64, s3, 1
    s_lshl_b32 s64, s64, 2
    v_add_u32 v46, s64, v91
    v_lshl_add_u32 v24, v46, 12, v45
    v_add_u32 v24, s72, v24
    v_mul_u32_u24 v25, 272, v46
    v_add_u32 v25, v25, v45
    v_and_b32 v46, 7, v92
    v_mul_u32_u24 v26, 272, v46
    v_lshl_add_u32 v26, v91, 4, v26
    s_cmp_lg_u32 s3, 6
    s_cbranch_scc1 L_fa1
    v_lshlrev_b32 v24, 12, v46
L_fa1:
    s_lshl2_add_u32 s64, s66, s3
    s_lshl_b32 s64, s64, 6
    s_add_u32 s64, s64, s73
    v_lshl_add_u32 v27, v90, 2, s64
    s_lshl_b32 s64, s3, 8
    v_mul_u32_u24 v28, 1792, v91
    v_add3_u32 v28, v28, v45, s64
    s_lshl_b32 s64, s3, 7
    s_add_u32 s64, s64, 19968
    v_lshl_add_u32 v30, v91, 4, s64
    v_and_b32 v46, 12, v90
    v_lshl_add_u32 v29, v46, 2, s64
    v_and_b32 v46, 1, v90
    v_lshl_add_u32 v29, v46, 3, v29
    v_and_b32 v46, 2, v90
    v_lshl_add_u32 v29, v46, 5, v29
    v_and_b32 v46, 2, v91
    v_add_u32 v29, v29, v46
    v_and_b32 v46, 1, v91
    v_lshl_add_u32 v29, v46, 2, v29
    s_lshl_b32 s64, s3, 2
    s_add_u32 s64, s64, 20992
    v_lshl_add_u32 v31, v90, 5, s64
    v_mov_b32 v35, 19712
    v_mov_b32 v32, 0
    s_mov_b32 s34, 0
    s_mov_b32 s32, 2
    s_mov_b32 s39, 8388608
    s_mov_b32 s86, 8388608
    s_mov_b32 s87, 8388608
    s_waitcnt lgkmcnt(0)
L_finit:
    s_mov_b32 s32, 0
    s_mov_b32 s47, 65536
    s_lshl_b32 s39, s26, 13
    s_add_u32 s39, s39, 131072
    s_lshl_b32 s86, s26, 10
    s_lshl_b32 s64, s27, 5
    s_add_u32 s86, s86, s64
    s_add_u32 s86, s86, 32768
    s_lshl_b32 s87, s26, 8
    s_lshl3_add_u32 s87, s27, s87
    s_add_u32 s87, s87, 20480
    s_lshl_b32 s64, s3, 10
    v_lshl_add_u32 v40, v92, 4, s64
    v_lshl_add_u32 v41, v91, 8, s64
    v_lshl_add_u32 v41, v90, 3, v41
    s_and_b32 s64, s3, 3
    s_mul_i32 s64, s64, 4160
    v_lshl_add_u32 v42, v91, 8, s64
    v_lshl_add_u32 v42, v90, 3, v42
    v_mov_b32 v33, s51
    s_lshl3_add_u32 s65, s27, s74
    s_waitcnt vmcnt(0)
    v_mov_b32 v122, s33
    v_add_u32 v32, 1, v122
    ds_write_b128 v124, v[110:113]
    ds_write_b128 v124, v[114:117] offset:16
    v_readfirstlane_b32 s33, v32
    s_cmp_lg_u32 s3, 0
    s_nop 2
    s_cbranch_scc1 L_fi1
    s_mov_b64 exec, 1
    buffer_store_dwordx2 v[32:33], off, s[8:11], s65
    s_mov_b64 exec, -1
L_fi1:
    s_waitcnt lgkmcnt(0)
    s_barrier
    ds_read_b64_tr_b16 v[4:5], v42 offset:0
    ds_read_b64_tr_b16 v[6:7], v42 offset:128
    ds_read_b64_tr_b16 v[8:9], v42 offset:1024
    ds_read_b64_tr_b16 v[10:11], v42 offset:1152
    ds_read_b64_tr_b16 v[12:13], v42 offset:2048
    ds_read_b64_tr_b16 v[14:15], v42 offset:2176
    ds_read_b64_tr_b16 v[16:17], v42 offset:3072
    ds_read_b64_tr_b16 v[18:19], v42 offset:3200
    s_cmp_lg_u32 s3, 0
    s_cbranch_scc1 L_fi3
    s_movk_i32 s53, 80
    s_branch L_fl
L_fl_r:
    s_sub_u32 s53, s53, 1
    s_cbranch_scc1 L_fslowtab
    s_sleep 4
L_fl:
    buffer_load_dwordx2 v[44:45], v88, s[8:11], s46 offen sc1
    buffer_load_dwordx2 v[46:47], v88, s[8:11], s74 offen sc1
    s_waitcnt vmcnt(0)
    v_cmp_ne_u32 vcc, s33, v44
    v_cmp_ne_u32 s[64:65], s33, v46
    s_nop 0
    s_or_b64 vcc, vcc, s[64:65]
    s_cbranch_vccnz L_fl_r
    v_cmp_ne_u32 vcc, s51, v45
    v_cmp_ne_u32 s[64:65], s51, v47
    s_nop 0
    s_or_b64 vcc, vcc, s[64:65]
    s_nop 1
    s_cbranch_vccnz L_fslowtab
    s_mov_b32 s34, 1
L_fi2:
    v_mov_b32 v46, s34
    ds_write_b32 v35, v46 offset:4
L_fi3:
    s_waitcnt vmcnt(0) lgkmcnt(0)
    s_barrier
    ds_read_b32 v46, v35 offset:4
    s_waitcnt lgkmcnt(0)
    v_readfirstlane_b32 s34, v46
    s_sleep 26
    s_cmp_lg_u32 s3, 7
    s_nop 1
    s_cbranch_scc1 L_nt7
    v_and_b32 v44, 1, v91
    v_lshlrev_b32 v44, 16, v44
    v_lshl_add_u32 v44, v90, 4, v44
    s_lshl_b32 s64, s27, 8
    s_add_u32 s64, s64, s39
    buffer_load_dword v45, v44, s[8:11], s64 offen sc1
    buffer_load_dword v47, off, s[8:11], s87 sc1
    buffer_load_dword v48, off, s[8:11], s87 offset:2048 sc1
L_nt7:
    global_load_dwordx4 v[118:121], v127, s[22:23]
    s_waitcnt vmcnt(0)
    v_mov_b32 v110, v40
    v_mov_b32 v111, v41
L_frnd:
    s_add_u32 s46, s46, 2048
    s_cmp_lg_u32 s3, 0
    s_cbranch_scc1 L_fb1
    s_cmp_eq_u32 s34, 0
    s_cbranch_scc1 L_fb1
L_ftrig_r:
    s_sub_u32 s50, s50, 1
    s_cbranch_scc1 L_end
    s_sleep 2
L_ftrig:
    buffer_load_dword v40, v88, s[8:11], s46 offen sc1
    s_waitcnt vmcnt(0)
    v_cmp_ne_u32 vcc, s33, v40
    s_cbranch_vccnz L_ftrig_r
    s_cmp_eq_u32 s32, 0
    s_cbranch_scc1 L_ft0
    s_sleep 14
    s_branch L_fb1
L_ft0:
    s_sleep 1
L_fb1:
    s_cmp_lg_u32 s32, 0
    s_cbranch_scc1 L_fb1b
    s_barrier
    global_load_dwordx4 v[118:121], v125, s[22:23]
    s_waitcnt vmcnt(0)
    ds_write_b128 v110, v[118:121] offset:21504
    ds_read_b64_tr_b16 v[20:21], v111 offset:21504
    ds_read_b64_tr_b16 v[22:23], v111 offset:21632
    s_waitcnt lgkmcnt(0)
L_fb1b:
    s_sub_u32 s64, s3, 4
    s_cmp_lt_u32 s64, 2
    s_barrier
    s_cbranch_scc1 L_fx
    s_cmp_lg_u32 s3, 6
    s_cbranch_scc1 L_fb2
    s_mov_b64 exec, 0xff
    v_mov_b32 v41, 0
    ds_write_b32 v35, v41
    s_branch L_fhd
L_fhd_r:
    s_sub_u32 s50, s50, 1
    s_cbranch_scc1 L_end
    s_sleep 2
L_fhd:
    buffer_load_dword v40, v24, s[8:11], s47 offen offset:3072 sc1
    s_waitcnt vmcnt(0)
    v_cmp_eq_u32 vcc, -1, v40
    s_cbranch_vccnz L_fhd_r
    ds_max_u32 v35, v40
    s_mov_b64 exec, -1
    s_branch L_fb2
L_fx_r:
    s_sub_u32 s50, s50, 1
    s_cbranch_scc1 L_end
    s_mov_b64 exec, vcc
    s_sleep 2
L_fx:
    buffer_load_dwordx4 v[40:43], v24, s[8:11], s47 offen sc1
    s_mov_b64 exec, -1
    s_waitcnt vmcnt(0)
    ds_write_b128 v25, v[40:43] offset:17408
    v_max3_u32 v44, v40, v41, v42
    v_max_u32 v44, v44, v43
    v_cmp_eq_u32 vcc, -1, v44
    s_cbranch_vccnz L_fx_r
L_fb2:
    s_cmp_gt_u32 s3, 3
    s_waitcnt lgkmcnt(0)
    s_barrier
    s_cbranch_scc1 L_fnoa
    ds_read_b32 v60, v35
    ds_read_b128 v[40:43], v26 offset:17408
    ds_read_b128 v[44:47], v26 offset:17472
    ds_read_b128 v[48:51], v26 offset:17536
    ds_read_b128 v[52:55], v26 offset:17600
    s_cmp_lt_u32 s27, 28
    s_cselect_b32 s40, s39, 8388608
    s_waitcnt lgkmcnt(3)
    v_mfma_f32_16x16x32_bf16 v[56:59], v[40:43], v[4:7], 0
    v_readfirstlane_b32 s35, v60
    s_waitcnt lgkmcnt(2)
    v_mfma_f32_16x16x32_bf16 v[56:59], v[44:47], v[8:11], v[56:59]
    s_andn2_b32 s64, 15, s35
    s_sub_u32 s65, 16, s64
    s_min_u32 s64, s64, s65
    s_waitcnt lgkmcnt(1)
    v_mfma_f32_16x16x32_bf16 v[56:59], v[48:51], v[12:15], v[56:59]
    s_bitcmp1_b32 s64, 0
    s_cselect_b64 vcc, -1, 0
    s_waitcnt lgkmcnt(0)
    v_mfma_f32_16x16x32_bf16 v[56:59], v[52:55], v[16:19], v[56:59]
    s_bitcmp1_b32 s64, 1
    s_cselect_b64 s[66:67], -1, 0
    s_and_b32 s64, s64, 4
    s_lshl_b32 s64, s64, 2
    s_bfm_b64 exec, 16, s64
    s_cmp_eq_u32 s34, 0
    s_nop 1
    v_cndmask_b32 v56, v56, v57, vcc
    v_cndmask_b32 v58, v58, v59, vcc
    v_cndmask_b32 v56, v56, v58, s[66:67]
    s_cbranch_scc1 L_fps_s
    buffer_store_dword v56, v27, s[8:11], s40 offen
L_fps_d:
    s_mov_b64 exec, -1
    s_cmp_eq_u32 s32, 2
    s_cbranch_scc1 L_fpok
    s_sleep 2
    s_branch L_fp
L_fps_s:
    buffer_store_dword v56, v27, s[8:11], s40 offen sc1
    s_branch L_fps_d
L_fnoa:
    s_cmp_eq_u32 s3, 7
    s_cbranch_scc1 L_f7
    s_cmp_eq_u32 s32, 2
    s_cbranch_scc1 L_fpok
    s_sleep 6
    s_branch L_fp
L_fp_r:
    s_sub_u32 s50, s50, 1
    s_cbranch_scc1 L_end
    s_mov_b64 exec, vcc
    s_sleep 1
L_fp:
    buffer_load_dwordx4 v[40:43], v28, s[8:11], s39 offen sc1
    s_mov_b64 exec, -1
    s_waitcnt vmcnt(0)
    v_max3_u32 v44, v40, v41, v42
    v_max_u32 v44, v44, v43
    v_cmp_eq_u32 vcc, -1, v44
    s_cbranch_vccnz L_fp_r
L_fpok:
    v_permlane32_swap_b32 v40, v41
    v_permlane32_swap_b32 v42, v43
    v_add_f32 v40, v40, v41
    v_add_f32 v42, v42, v43
    s_nop 1
    v_permlane16_swap_b32 v40, v42
    v_add_f32 v40, v40, v42
    v_mul_f32 v41, 0xbfb8aa3b, v40
    v_exp_f32 v41, v41
    v_mul_f32_dpp v42, v40, v40 quad_perm:[2,3,0,1] row_mask:0xf bank_mask:0xf
    v_add_f32 v41, 1.0, v41
    v_rcp_f32 v41, v41
    s_nop 0
    v_mul_f32 v41, v41, v42
    v_cvt_pk_bf16_f32 v41, v41, v41
    ds_write_b16 v29, v41
    ds_read_b128 v[44:47], v30
    s_waitcnt lgkmcnt(0)
    v_mfma_f32_16x16x32_bf16 v[48:51], v[44:47], v[20:23], 0
    s_mov_b64 exec, 0xffff
    s_nop 6
    ds_write_b32 v31, v48
    s_mov_b64 exec, -1
    s_waitcnt lgkmcnt(0)
    s_barrier
L_fnext:
    s_cmp_eq_u32 s32, 1
    s_cbranch_scc1 L_fend
    s_cmp_eq_u32 s32, 2
    s_cbranch_scc1 L_finit
    s_mov_b32 s32, 1
    s_add_u32 s47, s47, 32768
    s_add_u32 s39, s39, 65536
    s_add_u32 s86, s86, 8192
    s_add_u32 s87, s87, 2048
    s_branch L_frnd
L_f7:
    ds_read_b32 v33, v35
    v_mov_b32 v34, 0xbfb8aa3b
    v_add_u32 v48, -28, v31
    v_lshlrev_b32 v49, 1, v90
    s_waitcnt lgkmcnt(0)
    v_readfirstlane_b32 s35, v33
    s_nop 0
    s_ashr_i32 s64, s35, 31
    s_orn2_b32 s64, 0x80000000, s64
    s_xor_b32 s64, s64, s35
    v_mul_f32 v34, s64, v34
    v_exp_f32 v34, v34
    s_nop 0
    v_add_f32 v34, 1.0, v34
    v_rcp_f32 v34, v34
    s_barrier
    ds_read_b128 v[40:43], v48
    ds_read_b96 v[44:46], v48 offset:16
    s_mov_b64 exec, 1
    s_cmp_eq_u32 s34, 0
    s_cbranch_scc1 L_fyh_s
    buffer_store_dwordx2 v[32:33], off, s[8:11], s87
    s_branch L_fyh_d
L_fyh_s:
    buffer_store_dwordx2 v[32:33], off, s[8:11], s87 sc1
L_fyh_d:
    s_mov_b64 exec, -1
    s_waitcnt lgkmcnt(1)
    v_pk_add_f32 v[40:41], v[40:41], v[42:43]
    v_add_f32 v40, v40, v41
    s_waitcnt lgkmcnt(0)
    v_add_f32 v44, v44, v45
    v_add_f32 v40, v40, v46
    v_add_f32 v40, v40, v44
    v_mul_f32 v40, v40, v34
    s_nop 1
    v_mov_b32_dpp v41, v40 quad_perm:[1,1,3,3] row_mask:0xf bank_mask:0xf
    s_mov_b64 exec, 0x5555
    v_cvt_pk_bf16_f32 v40, v40, v41
    buffer_store_dword v40, v49, s[8:11], s86 offen sc1
    s_mov_b64 exec, -1
    s_branch L_fnext
L_fslowtab:
    v_and_b32 v56, 7, v92
    v_lshlrev_b32 v56, 7, v56
    s_mov_b32 s74, 4096
L_ftab2_r:
    s_sub_u32 s50, s50, 1
    s_cbranch_scc1 L_end
    s_sleep 8
L_ftab2:
    buffer_load_dword v44, v56, s[8:11], s74 offen sc1
    s_waitcnt vmcnt(0)
    v_cmp_ne_u32 vcc, s33, v44
    s_cbranch_vccnz L_ftab2_r
    s_branch L_fi2
L_fend:
    s_endpgm
L_end:
    s_endpgm
.section .rodata,"a"
.p2align 6
.amdhsa_kernel interleave_layers__spectral_fnet__moe_arch_mod__prompt_kernel
  .amdhsa_next_free_vgpr 128
  .amdhsa_next_free_sgpr 96
  .amdhsa_accum_offset 128
  .amdhsa_group_segment_fixed_size 0
  .amdhsa_kernarg_size 104
  .amdhsa_user_sgpr_count 2
  .amdhsa_user_sgpr_kernarg_segment_ptr 1
  .amdhsa_system_sgpr_workgroup_id_x 1
.end_amdhsa_kernel
```
